```python
import torch

def _softmax(x, axis=-1):
    return torch.softmax(x, dim=axis)
def _gelu(x):
    return torch.nn.functional.gelu(x, approximate="tanh")
def _silu(x):
    return torch.nn.functional.silu(x)
def _sigmoid(x):
    return torch.sigmoid(x)
def _layernorm(x, axis=-1, eps=1e-5):
    m = x.mean(dim=axis, keepdim=True)
    v = x.var(dim=axis, keepdim=True, unbiased=False)
    return (x - m) / torch.sqrt(v + eps)
def _scatter_add(tgt, idx, src, axis=0):
    return tgt.clone().index_add_(axis, idx, src)
def _segment_sum(src, seg, n):
    out = torch.zeros((n,) + src.shape[1:], dtype=src.dtype)
    return out.index_add_(0, seg, src)
def _pad(x, pw):
    flat = tuple(v for pair in reversed(pw) for v in pair)
    return torch.nn.functional.pad(x, flat)

kernel_name = 'standalone__spectral_fnet__prompt'

def setup_inputs():

    _w = (lambda a: (lambda t: t.to(torch.bfloat16) if t.is_floating_point() else t)(torch.as_tensor(a)))
    B, S, D = 1, 2048, 448
    ns = torch.arange(S)[:, None] * torch.arange(S)[None, :]
    nd = torch.arange(D)[:, None] * torch.arange(D)[None, :]
    Ws_re = torch.cos(-2.0 * torch.pi * ns / S).to(float)
    Ws_im = torch.sin(-2.0 * torch.pi * ns / S).to(float)
    Wd_re = torch.cos(-2.0 * torch.pi * nd / D).to(float)
    Wd_im = torch.sin(-2.0 * torch.pi * nd / D).to(float)
    return {
        "x": _w((lambda *s: torch.randn(*s, dtype=torch.bfloat16) * 0.05)(B, S, D)),
        "dft_seq_re": _w(Ws_re),
        "dft_seq_im": _w(Ws_im),
        "dft_hid_re": _w(Wd_re),
        "dft_hid_im": _w(Wd_im),
    }

def reference(x, dft_seq_re, dft_seq_im, dft_hid_re, dft_hid_im):
    a = torch.einsum("bsd,ed->bse", x, dft_hid_re)
    b = torch.einsum("bsd,ed->bse", x, dft_hid_im)
    y = torch.einsum("ts,bse->bte", dft_seq_re, a) - torch.einsum("ts,bse->bte", dft_seq_im, b)
    return y
```

```asm
; @launch grid=(256,1,1) block=(512,1,1) lds=153600
.amdgcn_target "amdgcn-amd-amdhsa--gfx950"
.text
.globl standalone__spectral_fnet__prompt_kernel
.p2align 8
.type standalone__spectral_fnet__prompt_kernel,@function
standalone__spectral_fnet__prompt_kernel:
    s_cmp_ge_u32 s2, 256
    s_cbranch_scc1 L_done
    s_load_dwordx8 s[4:11], s[0:1], 0
    s_load_dwordx4 s[12:15], s[0:1], 32
    s_load_dwordx4 s[56:59], s[0:1], 48
    v_lshrrev_b32 v2, 6, v0
    v_and_b32 v1, 63, v0
    v_readfirstlane_b32 s36, v2
    s_cmp_lg_u32 s36, 7
    s_cbranch_scc1 L_nopf
    s_getpc_b64 s[60:61]
L_pc:
    v_lshlrev_b32 v2, 7, v1
    v_min_u32 v2, L_end-L_pc-4, v2
    global_load_dword v4, v2, s[60:61]
L_nopf:
    s_and_b32 s37, s2, 7
    s_lshr_b32 s38, s2, 3
    s_and_b32 s43, s38, 3
    s_lshr_b32 s41, s38, 2
    s_and_b32 s41, s41, 1
    s_lshr_b32 s46, s38, 3
    s_lshl_b32 s42, s46, 3
    s_add_u32 s42, s42, s37
    s_mul_i32 s46, s46, 4
    s_lshr_b32 s39, s43, 1
    s_mul_i32 s39, s39, 4
    s_add_u32 s46, s46, s39
    s_and_b32 s46, s46, 7
    s_and_b32 s46, s46, 15
    v_lshlrev_b32 v14, 4, v1
    s_cmp_eq_u32 s36, 5
    s_cbranch_scc1 L_ldx
    s_cmp_ge_u32 s36, 6
    s_cbranch_scc1 L_aux
    s_cmp_lt_u32 s36, 4
    s_cbranch_scc1 L_comp
L_ldc:
    v_lshrrev_b32 v2, 3, v1
    v_lshlrev_b32 v2, 12, v2
    v_and_b32 v3, 7, v1
    v_lshrrev_b32 v4, 4, v1
    v_xor_b32 v3, v3, v4
    v_lshl_add_u32 v16, v3, 4, v2
    v_xor_b32 v3, 4, v3
    v_lshl_add_u32 v17, v3, 4, v2
    v_add_u32 v17, 31744, v17
    v_add_u32 v18, 63488, v16
    v_add_u32 v19, 63488, v17
    s_lshl_b32 s47, s42, 18
    s_lshl_b32 s37, s41, 11
    s_add_u32 s47, s47, s37
    s_waitcnt lgkmcnt(0)
    s_mov_b32 s16, s6
    s_and_b32 s17, s7, 0xffff
    s_mov_b32 s18, 8388608
    s_mov_b32 s19, 0x20000
    s_mov_b32 s20, s8
    s_and_b32 s21, s9, 0xffff
    s_mov_b32 s22, 8388608
    s_mov_b32 s23, 0x20000
    s_mul_i32 s48, s46, 128
    s_add_u32 s48, s48, s47
    s_mov_b32 s50, 0
    s_mov_b32 s51, 0
L_ldc_loop:
    s_cmp_lt_u32 s51, 3
    s_cbranch_scc1 L_ldc_issue
    s_waitcnt vmcnt(32)
    s_barrier
L_ldc_issue:
    s_add_u32 s49, s48, 131072
    s_add_u32 m0, s50, 0
    s_nop 0
    buffer_load_dwordx4 v16, s[16:19], s48 offen offset:0 lds
    buffer_load_dwordx4 v17, s[16:19], s48 offen offset:1024 lds
    buffer_load_dwordx4 v18, s[16:19], s48 offen offset:2048 lds
    buffer_load_dwordx4 v19, s[16:19], s48 offen offset:3072 lds
    s_add_u32 m0, s50, 4096
    s_nop 0
    buffer_load_dwordx4 v16, s[16:19], s49 offen offset:0 lds
    buffer_load_dwordx4 v17, s[16:19], s49 offen offset:1024 lds
    buffer_load_dwordx4 v18, s[16:19], s49 offen offset:2048 lds
    buffer_load_dwordx4 v19, s[16:19], s49 offen offset:3072 lds
    s_add_u32 m0, s50, 8192
    s_nop 0
    buffer_load_dwordx4 v16, s[20:23], s48 offen offset:0 lds
    buffer_load_dwordx4 v17, s[20:23], s48 offen offset:1024 lds
    buffer_load_dwordx4 v18, s[20:23], s48 offen offset:2048 lds
    buffer_load_dwordx4 v19, s[20:23], s48 offen offset:3072 lds
    s_add_u32 m0, s50, 12288
    s_nop 0
    buffer_load_dwordx4 v16, s[20:23], s49 offen offset:0 lds
    buffer_load_dwordx4 v17, s[20:23], s49 offen offset:1024 lds
    buffer_load_dwordx4 v18, s[20:23], s49 offen offset:2048 lds
    buffer_load_dwordx4 v19, s[20:23], s49 offen offset:3072 lds
    s_add_u32 s46, s46, 1
    s_and_b32 s46, s46, 7
    s_add_u32 s48, s51, 1
    s_and_b32 s48, s48, 8
    s_add_u32 s48, s48, s46
    s_mul_i32 s48, s48, 128
    s_add_u32 s48, s48, s47
    s_add_u32 s50, s50, 30720
    s_cmp_eq_u32 s50, 153600
    s_cselect_b32 s50, 0, s50
    s_add_u32 s51, s51, 1
    s_cmp_lt_u32 s51, 16
    s_cbranch_scc1 L_ldc_loop
    s_branch L_ldtail
L_ldx:
    v_mul_u32_u24 v3, 4682, v1
    v_lshrrev_b32 v3, 16, v3
    v_lshlrev_b32 v4, 4, v1
    v_mul_u32_u24 v5, 224, v3
    v_sub_u32 v4, v4, v5
    v_lshrrev_b32 v5, 1, v3
    v_and_b32 v5, 4, v5
    v_xor_b32 v3, v3, v5
    v_mul_u32_u24 v3, 896, v3
    v_add_u32 v16, v4, v3
    v_add_u32 v23, 25600, v16
    v_add_u32 v2, 64, v1
    v_mul_u32_u24 v3, 4682, v2
    v_lshrrev_b32 v3, 16, v3
    v_lshlrev_b32 v4, 4, v2
    v_mul_u32_u24 v5, 224, v3
    v_sub_u32 v4, v4, v5
    v_lshrrev_b32 v5, 1, v3
    v_and_b32 v5, 4, v5
    v_xor_b32 v3, v3, v5
    v_mul_u32_u24 v3, 896, v3
    v_add_u32 v17, v4, v3
    v_add_u32 v24, 28672, v17
    v_subrev_u32 v17, 1024, v17
    v_add_u32 v2, 128, v1
    v_mul_u32_u24 v3, 4682, v2
    v_lshrrev_b32 v3, 16, v3
    v_lshlrev_b32 v4, 4, v2
    v_mul_u32_u24 v5, 224, v3
    v_sub_u32 v4, v4, v5
    v_lshrrev_b32 v5, 1, v3
    v_and_b32 v5, 4, v5
    v_xor_b32 v3, v3, v5
    v_mul_u32_u24 v3, 896, v3
    v_add_u32 v18, v4, v3
    v_add_u32 v25, 27648, v18
    v_subrev_u32 v18, 2048, v18
    v_add_u32 v2, 192, v1
    v_mul_u32_u24 v3, 4682, v2
    v_lshrrev_b32 v3, 16, v3
    v_lshlrev_b32 v4, 4, v2
    v_mul_u32_u24 v5, 224, v3
    v_sub_u32 v4, v4, v5
    v_lshrrev_b32 v5, 1, v3
    v_and_b32 v5, 4, v5
    v_xor_b32 v3, v3, v5
    v_mul_u32_u24 v3, 896, v3
    v_add_u32 v19, v4, v3
    v_add_u32 v26, 26624, v19
    v_subrev_u32 v19, 3072, v19
    v_add_u32 v2, 256, v1
    v_mul_u32_u24 v3, 4682, v2
    v_lshrrev_b32 v3, 16, v3
    v_lshlrev_b32 v4, 4, v2
    v_mul_u32_u24 v5, 224, v3
    v_sub_u32 v4, v4, v5
    v_lshrrev_b32 v5, 1, v3
    v_and_b32 v5, 4, v5
    v_xor_b32 v3, v3, v5
    v_mul_u32_u24 v3, 896, v3
    v_add_u32 v20, v4, v3
    v_add_u32 v27, 25600, v20
    v_add_u32 v2, 320, v1
    v_mul_u32_u24 v3, 4682, v2
    v_lshrrev_b32 v3, 16, v3
    v_lshlrev_b32 v4, 4, v2
    v_mul_u32_u24 v5, 224, v3
    v_sub_u32 v4, v4, v5
    v_lshrrev_b32 v5, 1, v3
    v_and_b32 v5, 4, v5
    v_xor_b32 v3, v3, v5
    v_mul_u32_u24 v3, 896, v3
    v_add_u32 v21, v4, v3
    v_add_u32 v28, 28672, v21
    v_subrev_u32 v21, 1024, v21
    v_add_u32 v2, 384, v1
    v_mul_u32_u24 v3, 4682, v2
    v_lshrrev_b32 v3, 16, v3
    v_lshlrev_b32 v4, 4, v2
    v_mul_u32_u24 v5, 224, v3
    v_sub_u32 v4, v4, v5
    v_lshrrev_b32 v5, 1, v3
    v_and_b32 v5, 4, v5
    v_xor_b32 v3, v3, v5
    v_mul_u32_u24 v3, 896, v3
    v_add_u32 v22, v4, v3
    v_add_u32 v29, 27648, v22
    v_subrev_u32 v22, 2048, v22
    s_mul_i32 s47, s41, 917504
    s_mul_i32 s37, s43, 224
    s_add_u32 s47, s47, s37
    s_waitcnt lgkmcnt(0)
    s_mov_b32 s16, s4
    s_and_b32 s17, s5, 0xffff
    s_mov_b32 s18, 1835008
    s_mov_b32 s19, 0x20000
    s_mul_i32 s48, s46, 57344
    s_add_u32 s48, s48, s47
    s_mov_b32 s50, 0
    s_mov_b32 s51, 0
L_ldx_loop:
    s_cmp_lt_u32 s51, 3
    s_cbranch_scc1 L_ldx_issue
    s_waitcnt vmcnt(28)
    s_barrier
L_ldx_issue:
    s_add_u32 m0, s50, 16384
    s_nop 0
    buffer_load_dwordx4 v16, s[16:19], s48 offen offset:0 lds
    buffer_load_dwordx4 v17, s[16:19], s48 offen offset:1024 lds
    buffer_load_dwordx4 v18, s[16:19], s48 offen offset:2048 lds
    buffer_load_dwordx4 v19, s[16:19], s48 offen offset:3072 lds
    s_add_u32 m0, s50, 20480
    s_nop 0
    buffer_load_dwordx4 v20, s[16:19], s48 offen offset:0 lds
    buffer_load_dwordx4 v21, s[16:19], s48 offen offset:1024 lds
    buffer_load_dwordx4 v22, s[16:19], s48 offen offset:2048 lds
    buffer_load_dwordx4 v23, s[16:19], s48 offen offset:3072 lds
    s_add_u32 m0, s50, 24576
    s_nop 0
    buffer_load_dwordx4 v24, s[16:19], s48 offen offset:0 lds
    buffer_load_dwordx4 v25, s[16:19], s48 offen offset:1024 lds
    buffer_load_dwordx4 v26, s[16:19], s48 offen offset:2048 lds
    buffer_load_dwordx4 v27, s[16:19], s48 offen offset:3072 lds
    s_add_u32 m0, s50, 28672
    s_nop 0
    buffer_load_dwordx4 v28, s[16:19], s48 offen offset:0 lds
    buffer_load_dwordx4 v29, s[16:19], s48 offen offset:1024 lds
    s_add_u32 s46, s46, 1
    s_and_b32 s46, s46, 7
    s_add_u32 s48, s51, 1
    s_and_b32 s48, s48, 8
    s_add_u32 s48, s48, s46
    s_mul_i32 s48, s48, 57344
    s_add_u32 s48, s48, s47
    s_add_u32 s50, s50, 30720
    s_cmp_eq_u32 s50, 153600
    s_cselect_b32 s50, 0, s50
    s_add_u32 s51, s51, 1
    s_cmp_lt_u32 s51, 16
    s_cbranch_scc1 L_ldx_loop
    s_branch L_ldtail
L_comp:
    v_and_b32 v2, 15, v1
    v_lshrrev_b32 v3, 4, v1
    v_lshrrev_b32 v5, 1, v2
    v_xor_b32 v4, v3, v5
    v_lshlrev_b32 v4, 4, v4
    v_lshl_add_u32 v6, v2, 7, v4
    s_lshl_b32 s37, s36, 11
    v_add_u32 v6, s37, v6
    v_xor_b32 v7, 64, v6
    v_lshlrev_b32 v4, 3, v3
    v_lshrrev_b32 v5, 2, v2
    v_add_u32 v4, v4, v5
    v_and_b32 v5, 1, v3
    v_lshlrev_b32 v5, 2, v5
    v_add_u32 v8, v4, v5
    v_xor_b32 v5, 4, v5
    v_add_u32 v9, v4, v5
    v_and_b32 v2, 3, v2
    v_lshlrev_b32 v2, 3, v2
    v_add_u32 v2, 16384, v2
    v_mov_b32 v3, 224
    v_mad_u32_u24 v8, v8, v3, v2
    v_mad_u32_u24 v9, v9, v3, v2
    v_mov_b32 v52, 0
    v_mov_b32 v53, 0
    v_mov_b32 v54, 0
    v_mov_b32 v55, 0
    v_mov_b32 v56, 0
    v_mov_b32 v57, 0
    v_mov_b32 v58, 0
    v_mov_b32 v59, 0
    v_mov_b32 v60, 0
    v_mov_b32 v61, 0
    v_mov_b32 v62, 0
    v_mov_b32 v63, 0
    v_mov_b32 v64, 0
    v_mov_b32 v65, 0
    v_mov_b32 v66, 0
    v_mov_b32 v67, 0
    v_mov_b32 v68, 0
    v_mov_b32 v69, 0
    v_mov_b32 v70, 0
    v_mov_b32 v71, 0
    v_mov_b32 v72, 0
    v_mov_b32 v73, 0
    v_mov_b32 v74, 0
    v_mov_b32 v75, 0
    v_mov_b32 v76, 0
    v_mov_b32 v77, 0
    v_mov_b32 v78, 0
    v_mov_b32 v79, 0
    v_mov_b32 v80, 0
    v_mov_b32 v81, 0
    v_mov_b32 v82, 0
    v_mov_b32 v83, 0
    v_mov_b32 v84, 0
    v_mov_b32 v85, 0
    v_mov_b32 v86, 0
    v_mov_b32 v87, 0
    v_mov_b32 v88, 0
    v_mov_b32 v89, 0
    v_mov_b32 v90, 0
    v_mov_b32 v91, 0
    v_mov_b32 v92, 0
    v_mov_b32 v93, 0
    v_mov_b32 v94, 0
    v_mov_b32 v95, 0
    v_mov_b32 v96, 0
    v_mov_b32 v97, 0
    v_mov_b32 v98, 0
    v_mov_b32 v99, 0
    v_mov_b32 v100, 0
    v_mov_b32 v101, 0
    v_mov_b32 v102, 0
    v_mov_b32 v103, 0
    v_mov_b32 v104, 0
    v_mov_b32 v105, 0
    v_mov_b32 v106, 0
    v_mov_b32 v107, 0
    v_mov_b32 v108, 0
    v_mov_b32 v109, 0
    v_mov_b32 v110, 0
    v_mov_b32 v111, 0
    v_mov_b32 v112, 0
    v_mov_b32 v113, 0
    v_mov_b32 v114, 0
    v_mov_b32 v115, 0
    v_mov_b32 v116, 0
    v_mov_b32 v117, 0
    v_mov_b32 v118, 0
    v_mov_b32 v119, 0
    v_mov_b32 v120, 0
    v_mov_b32 v121, 0
    v_mov_b32 v122, 0
    v_mov_b32 v123, 0
    v_mov_b32 v124, 0
    v_mov_b32 v125, 0
    v_mov_b32 v126, 0
    v_mov_b32 v127, 0
    v_mov_b32 v128, 0
    v_mov_b32 v129, 0
    v_mov_b32 v130, 0
    v_mov_b32 v131, 0
    v_mov_b32 v132, 0
    v_mov_b32 v133, 0
    v_mov_b32 v134, 0
    v_mov_b32 v135, 0
    v_mov_b32 v136, 0
    v_mov_b32 v137, 0
    v_mov_b32 v138, 0
    v_mov_b32 v139, 0
    v_mov_b32 v140, 0
    v_mov_b32 v141, 0
    v_mov_b32 v142, 0
    v_mov_b32 v143, 0
    v_mov_b32 v10, v6
    v_mov_b32 v12, v8
    v_mov_b32 v11, v7
    v_mov_b32 v13, v9
    v_add_u32 v15, 4096, v14
    s_lshl_b32 s48, s41, 7
    s_lshl_b32 s38, s42, 2
    s_add_u32 s48, s48, s38
    s_add_u32 s48, s48, s36
    s_mul_i32 s48, s48, 28
    s_mul_i32 s38, s43, 7
    s_add_u32 s48, s48, s38
    s_lshl_b32 s48, s48, 10
    s_and_b32 s37, s36, 1
    s_mul_i32 s37, s37, 14
    s_lshr_b32 s38, s36, 1
    s_mul_i32 s39, s38, 56
    s_add_u32 s37, s37, s39
    s_mul_i32 s39, s43, 196
    s_add_u32 s37, s37, s39
    s_lshl_b32 s37, s37, 10
    s_add_u32 s60, s37, 7340032
    s_add_u32 s61, s37, 7368704
    s_cmp_eq_u32 s38, 3
    s_cselect_b32 s61, 0x7f000000, s61
    s_and_b32 s37, s36, 3
    s_lshr_b32 s38, s36, 2
    s_mul_i32 s38, s38, 14
    s_mul_i32 s63, s37, 28
    s_add_u32 s63, s63, s38
    s_lshl_b32 s63, s63, 10
    s_lshr_b32 s39, s37, 1
    s_lshl_b32 s39, s39, 7
    s_and_b32 s37, s37, 1
    s_add_u32 s37, s37, s39
    s_lshl_b32 s39, s42, 2
    s_add_u32 s37, s37, s39
    s_lshl_b32 s39, s41, 1
    s_add_u32 s37, s37, s39
    s_mul_i32 s37, s37, 28
    s_add_u32 s37, s37, s38
    s_lshl_b32 s62, s37, 10
    v_mov_b32 v2, v14
    v_add_u32 v3, 4096, v14
    v_add_u32 v4, 8192, v14
    v_add_u32 v5, 12288, v14
    s_waitcnt lgkmcnt(0)
    s_mov_b32 s24, s58
    s_and_b32 s25, s59, 0xffff
    s_mov_b32 s26, 8146944
    s_mov_b32 s27, 0x20000
    s_mov_b32 s50, 0
    s_mov_b32 s51, 0
L_loop:
    s_waitcnt lgkmcnt(0)
    s_barrier
    v_mfma_f32_16x16x32_bf16 v[88:91], v[60:63], v[52:55], v[88:91]
    ds_read_b64_tr_b16 v[24:25], v12 offset:0
    ds_read_b64_tr_b16 v[26:27], v13 offset:0
    v_mfma_f32_16x16x32_bf16 v[92:95], v[60:63], v[56:59], v[92:95]
    ds_read_b128 v[16:19], v10 offset:0
    ds_read_b128 v[20:23], v10 offset:8192
    v_mfma_f32_16x16x32_bf16 v[96:99], v[64:67], v[52:55], v[96:99]
    ds_read_b64_tr_b16 v[28:29], v12 offset:32
    ds_read_b64_tr_b16 v[30:31], v13 offset:32
    v_mfma_f32_16x16x32_bf16 v[100:103], v[64:67], v[56:59], v[100:103]
    ds_read_b64_tr_b16 v[32:33], v12 offset:64
    ds_read_b64_tr_b16 v[34:35], v13 offset:64
    v_mfma_f32_16x16x32_bf16 v[104:107], v[68:71], v[52:55], v[104:107]
    ds_read_b64_tr_b16 v[36:37], v12 offset:96
    ds_read_b64_tr_b16 v[38:39], v13 offset:96
    v_mfma_f32_16x16x32_bf16 v[108:111], v[68:71], v[56:59], v[108:111]
    ds_read_b64_tr_b16 v[40:41], v12 offset:128
    ds_read_b64_tr_b16 v[42:43], v13 offset:128
    v_mfma_f32_16x16x32_bf16 v[112:115], v[72:75], v[52:55], v[112:115]
    ds_read_b64_tr_b16 v[44:45], v12 offset:160
    ds_read_b64_tr_b16 v[46:47], v13 offset:160
    v_mfma_f32_16x16x32_bf16 v[116:119], v[72:75], v[56:59], v[116:119]
    ds_read_b64_tr_b16 v[48:49], v12 offset:192
    ds_read_b64_tr_b16 v[50:51], v13 offset:192
    v_mfma_f32_16x16x32_bf16 v[120:123], v[76:79], v[52:55], v[120:123]
    s_add_u32 s50, s50, 30720
    s_cmp_eq_u32 s50, 153600
    s_cselect_b32 s50, 0, s50
    v_mfma_f32_16x16x32_bf16 v[124:127], v[76:79], v[56:59], v[124:127]
    v_mfma_f32_16x16x32_bf16 v[128:131], v[80:83], v[52:55], v[128:131]
    v_mfma_f32_16x16x32_bf16 v[132:135], v[80:83], v[56:59], v[132:135]
    v_mfma_f32_16x16x32_bf16 v[136:139], v[84:87], v[52:55], v[136:139]
    v_mfma_f32_16x16x32_bf16 v[140:143], v[84:87], v[56:59], v[140:143]
    s_waitcnt lgkmcnt(0)
    v_mfma_f32_16x16x32_bf16 v[88:91], v[24:27], v[16:19], v[88:91]
    ds_read_b64_tr_b16 v[60:61], v12 offset:7168
    ds_read_b64_tr_b16 v[62:63], v13 offset:7168
    v_mfma_f32_16x16x32_bf16 v[92:95], v[24:27], v[20:23], v[92:95]
    ds_read_b128 v[52:55], v11 offset:0
    ds_read_b128 v[56:59], v11 offset:8192
    v_mfma_f32_16x16x32_bf16 v[96:99], v[28:31], v[16:19], v[96:99]
    ds_read_b64_tr_b16 v[64:65], v12 offset:7200
    ds_read_b64_tr_b16 v[66:67], v13 offset:7200
    v_mfma_f32_16x16x32_bf16 v[100:103], v[28:31], v[20:23], v[100:103]
    ds_read_b64_tr_b16 v[68:69], v12 offset:7232
    ds_read_b64_tr_b16 v[70:71], v13 offset:7232
    v_mfma_f32_16x16x32_bf16 v[104:107], v[32:35], v[16:19], v[104:107]
    ds_read_b64_tr_b16 v[72:73], v12 offset:7264
    ds_read_b64_tr_b16 v[74:75], v13 offset:7264
    v_mfma_f32_16x16x32_bf16 v[108:111], v[32:35], v[20:23], v[108:111]
    ds_read_b64_tr_b16 v[76:77], v12 offset:7296
    ds_read_b64_tr_b16 v[78:79], v13 offset:7296
    v_mfma_f32_16x16x32_bf16 v[112:115], v[36:39], v[16:19], v[112:115]
    ds_read_b64_tr_b16 v[80:81], v12 offset:7328
    ds_read_b64_tr_b16 v[82:83], v13 offset:7328
    v_mfma_f32_16x16x32_bf16 v[116:119], v[36:39], v[20:23], v[116:119]
    ds_read_b64_tr_b16 v[84:85], v12 offset:7360
    ds_read_b64_tr_b16 v[86:87], v13 offset:7360
    v_mfma_f32_16x16x32_bf16 v[120:123], v[40:43], v[16:19], v[120:123]
    v_add_u32 v10, s50, v6
    v_add_u32 v11, s50, v7
    v_mfma_f32_16x16x32_bf16 v[124:127], v[40:43], v[20:23], v[124:127]
    v_add_u32 v12, s50, v8
    v_add_u32 v13, s50, v9
    v_mfma_f32_16x16x32_bf16 v[128:131], v[44:47], v[16:19], v[128:131]
    s_add_u32 s51, s51, 1
    s_cmp_lt_u32 s51, 16
    v_mfma_f32_16x16x32_bf16 v[132:135], v[44:47], v[20:23], v[132:135]
    v_mfma_f32_16x16x32_bf16 v[136:139], v[48:51], v[16:19], v[136:139]
    v_mfma_f32_16x16x32_bf16 v[140:143], v[48:51], v[20:23], v[140:143]
    s_cbranch_scc1 L_loop
    s_waitcnt lgkmcnt(0)
    v_mfma_f32_16x16x32_bf16 v[88:91], v[60:63], v[52:55], v[88:91]
    v_mfma_f32_16x16x32_bf16 v[92:95], v[60:63], v[56:59], v[92:95]
    v_mfma_f32_16x16x32_bf16 v[96:99], v[64:67], v[52:55], v[96:99]
    v_mfma_f32_16x16x32_bf16 v[100:103], v[64:67], v[56:59], v[100:103]
    v_mfma_f32_16x16x32_bf16 v[104:107], v[68:71], v[52:55], v[104:107]
    v_mfma_f32_16x16x32_bf16 v[108:111], v[68:71], v[56:59], v[108:111]
    v_mfma_f32_16x16x32_bf16 v[112:115], v[72:75], v[52:55], v[112:115]
    v_mfma_f32_16x16x32_bf16 v[116:119], v[72:75], v[56:59], v[116:119]
    v_mfma_f32_16x16x32_bf16 v[120:123], v[76:79], v[52:55], v[120:123]
    v_mfma_f32_16x16x32_bf16 v[124:127], v[76:79], v[56:59], v[124:127]
    v_mfma_f32_16x16x32_bf16 v[128:131], v[80:83], v[52:55], v[128:131]
    v_mfma_f32_16x16x32_bf16 v[132:135], v[80:83], v[56:59], v[132:135]
    v_mfma_f32_16x16x32_bf16 v[136:139], v[84:87], v[52:55], v[136:139]
    v_mfma_f32_16x16x32_bf16 v[140:143], v[84:87], v[56:59], v[140:143]
    s_nop 4
    v_cvt_pk_bf16_f32 v16, v88, v89
    v_cvt_pk_bf16_f32 v17, v90, v91
    v_cvt_pk_bf16_f32 v18, v92, v93
    v_cvt_pk_bf16_f32 v19, v94, v95
    buffer_store_dwordx4 v[16:19], v14, s[24:27], s48 offen offset:0 sc1
    v_cvt_pk_bf16_f32 v20, v96, v97
    v_cvt_pk_bf16_f32 v21, v98, v99
    v_cvt_pk_bf16_f32 v22, v100, v101
    v_cvt_pk_bf16_f32 v23, v102, v103
    buffer_store_dwordx4 v[20:23], v14, s[24:27], s48 offen offset:1024 sc1
    v_cvt_pk_bf16_f32 v24, v104, v105
    v_cvt_pk_bf16_f32 v25, v106, v107
    v_cvt_pk_bf16_f32 v26, v108, v109
    v_cvt_pk_bf16_f32 v27, v110, v111
    buffer_store_dwordx4 v[24:27], v14, s[24:27], s48 offen offset:2048 sc1
    v_cvt_pk_bf16_f32 v28, v112, v113
    v_cvt_pk_bf16_f32 v29, v114, v115
    v_cvt_pk_bf16_f32 v30, v116, v117
    v_cvt_pk_bf16_f32 v31, v118, v119
    buffer_store_dwordx4 v[28:31], v14, s[24:27], s48 offen offset:3072 sc1
    v_cvt_pk_bf16_f32 v32, v120, v121
    v_cvt_pk_bf16_f32 v33, v122, v123
    v_cvt_pk_bf16_f32 v34, v124, v125
    v_cvt_pk_bf16_f32 v35, v126, v127
    buffer_store_dwordx4 v[32:35], v15, s[24:27], s48 offen offset:0 sc1
    v_cvt_pk_bf16_f32 v36, v128, v129
    v_cvt_pk_bf16_f32 v37, v130, v131
    v_cvt_pk_bf16_f32 v38, v132, v133
    v_cvt_pk_bf16_f32 v39, v134, v135
    buffer_store_dwordx4 v[36:39], v15, s[24:27], s48 offen offset:1024 sc1
    v_cvt_pk_bf16_f32 v40, v136, v137
    v_cvt_pk_bf16_f32 v41, v138, v139
    v_cvt_pk_bf16_f32 v42, v140, v141
    v_cvt_pk_bf16_f32 v43, v142, v143
    buffer_store_dwordx4 v[40:43], v15, s[24:27], s48 offen offset:2048 sc1
L_st_done:
    buffer_load_dwordx4 v[144:147], v2, s[24:27], s60 offen offset:0 sc1
    buffer_load_dwordx4 v[148:151], v2, s[24:27], s61 offen offset:0 sc1
    buffer_load_dwordx4 v[152:155], v2, s[24:27], s60 offen offset:1024 sc1
    buffer_load_dwordx4 v[156:159], v2, s[24:27], s61 offen offset:1024 sc1
    buffer_load_dwordx4 v[160:163], v2, s[24:27], s60 offen offset:2048 sc1
    buffer_load_dwordx4 v[164:167], v2, s[24:27], s61 offen offset:2048 sc1
    buffer_load_dwordx4 v[168:171], v2, s[24:27], s60 offen offset:3072 sc1
    buffer_load_dwordx4 v[172:175], v2, s[24:27], s61 offen offset:3072 sc1
    buffer_load_dwordx4 v[176:179], v3, s[24:27], s60 offen offset:0 sc1
    buffer_load_dwordx4 v[180:183], v3, s[24:27], s61 offen offset:0 sc1
    buffer_load_dwordx4 v[184:187], v3, s[24:27], s60 offen offset:1024 sc1
    buffer_load_dwordx4 v[188:191], v3, s[24:27], s61 offen offset:1024 sc1
    buffer_load_dwordx4 v[192:195], v3, s[24:27], s60 offen offset:2048 sc1
    buffer_load_dwordx4 v[196:199], v3, s[24:27], s61 offen offset:2048 sc1
    s_waitcnt vmcnt(14)
    s_barrier
    s_barrier
    buffer_load_dwordx4 v[200:203], v3, s[24:27], s60 offen offset:3072 sc1
    buffer_load_dwordx4 v[204:207], v3, s[24:27], s61 offen offset:3072 sc1
    buffer_load_dwordx4 v[208:211], v4, s[24:27], s60 offen offset:0 sc1
    buffer_load_dwordx4 v[212:215], v4, s[24:27], s61 offen offset:0 sc1
    buffer_load_dwordx4 v[216:219], v4, s[24:27], s60 offen offset:1024 sc1
    buffer_load_dwordx4 v[220:223], v4, s[24:27], s61 offen offset:1024 sc1
    buffer_load_dwordx4 v[224:227], v4, s[24:27], s60 offen offset:2048 sc1
    buffer_load_dwordx4 v[228:231], v4, s[24:27], s61 offen offset:2048 sc1
    buffer_load_dwordx4 v[232:235], v4, s[24:27], s60 offen offset:3072 sc1
    buffer_load_dwordx4 v[236:239], v4, s[24:27], s61 offen offset:3072 sc1
    buffer_load_dwordx4 v[240:243], v5, s[24:27], s60 offen offset:0 sc1
    buffer_load_dwordx4 v[244:247], v5, s[24:27], s61 offen offset:0 sc1
    buffer_load_dwordx4 v[248:251], v5, s[24:27], s60 offen offset:1024 sc1
    buffer_load_dwordx4 v[252:255], v5, s[24:27], s61 offen offset:1024 sc1
    s_branch L_p2_after
L_p2:
    s_barrier
    s_cmp_eq_u32 s36, 6
    s_cbranch_scc1 L_p2_after
    s_barrier
L_p2_after:
    v_mov_b32 v88, 0
    v_mov_b32 v89, 0
    v_mov_b32 v90, 0
    v_mov_b32 v91, 0
    v_mov_b32 v92, 0
    v_mov_b32 v93, 0
    v_mov_b32 v94, 0
    v_mov_b32 v95, 0
    v_mov_b32 v96, 0
    v_mov_b32 v97, 0
    v_mov_b32 v98, 0
    v_mov_b32 v99, 0
    v_mov_b32 v100, 0
    v_mov_b32 v101, 0
    v_mov_b32 v102, 0
    v_mov_b32 v103, 0
    s_cmp_eq_u32 s36, 6
    s_cbranch_scc0 L_p2_wait
    v_mov_b32 v2, 0
    s_mov_b32 s51, 0
    s_cmp_eq_u32 s53, 1
    s_cbranch_scc1 L_pub_loc
    s_mov_b32 s37, 0x10000000
    s_atomic_add s37, s[32:33], 0
    s_barrier
L_poll2:
    s_mov_b32 s39, 0
    s_atomic_add s39, s[32:33], 0 glc
    s_waitcnt lgkmcnt(0)
    s_add_u32 s51, s51, 1
    s_lshr_b32 s39, s39, 28
    s_cmp_eq_u32 s39, 8
    s_cbranch_scc1 L_poll_done
    s_sleep 16
    s_cmp_lt_u32 s51, 16384
    s_cbranch_scc1 L_poll2
    s_branch L_poll_done
L_pub_loc:
    s_lshl_b32 s38, s42, 7
    s_add_u32 s38, s38, 8142848
    s_and_b32 s37, s52, 7
    s_lshl_b32 s37, s37, 2
    s_add_u32 s37, s37, s38
    v_mov_b32 v3, 1
    v_lshlrev_b32 v5, 2, v1
    s_mov_b64 exec, 1
    buffer_store_dword v3, v2, s[24:27], s37 offen
    s_mov_b64 exec, 0xff
    buffer_load_dword v4, v5, s[24:27], s38 offen sc1
    s_barrier
    s_branch L_poll3b
L_poll3:
    buffer_load_dword v4, v5, s[24:27], s38 offen sc1
L_poll3b:
    s_waitcnt vmcnt(0)
    v_cmp_ne_u32 vcc, 1, v4
    s_add_u32 s51, s51, 1
    s_nop 3
    s_cmp_eq_u64 vcc, 0
    s_cbranch_scc1 L_poll_done
    s_cmp_lt_u32 s51, 16384
    s_cbranch_scc1 L_poll3
L_poll_done:
    s_mov_b64 exec, -1
L_p2_wait:
    s_and_b32 s37, s36, 1
    s_mul_i32 s37, s37, 14336
    v_add_u32 v10, s37, v14
    v_add_u32 v11, 57344, v10
    s_barrier
    s_add_u32 m0, s63, 0
    s_add_u32 s38, s62, 0
    buffer_load_dwordx4 v14, s[24:27], s38 offen offset:0 sc1 lds
    buffer_load_dwordx4 v14, s[24:27], s38 offen offset:1024 sc1 lds
    s_add_u32 m0, s63, 2048
    s_add_u32 s38, s62, 2048
    buffer_load_dwordx4 v14, s[24:27], s38 offen offset:0 sc1 lds
    buffer_load_dwordx4 v14, s[24:27], s38 offen offset:1024 sc1 lds
    buffer_load_dwordx4 v14, s[24:27], s38 offen offset:2048 sc1 lds
    s_waitcnt vmcnt(3)
    s_barrier
    ds_read_b128 v[16:19], v10 offset:0
    ds_read_b128 v[20:23], v10 offset:28672
    ds_read_b128 v[24:27], v11 offset:0
    ds_read_b128 v[28:31], v11 offset:28672
    ds_read_b128 v[32:35], v10 offset:1024
    ds_read_b128 v[36:39], v10 offset:29696
    ds_read_b128 v[40:43], v11 offset:1024
    ds_read_b128 v[44:47], v11 offset:29696
    s_add_u32 m0, s63, 5120
    s_add_u32 s38, s62, 5120
    buffer_load_dwordx4 v14, s[24:27], s38 offen offset:0 sc1 lds
    buffer_load_dwordx4 v14, s[24:27], s38 offen offset:1024 sc1 lds
    buffer_load_dwordx4 v14, s[24:27], s38 offen offset:2048 sc1 lds
    s_waitcnt lgkmcnt(4)
    v_mfma_f32_16x16x32_bf16 v[88:91], v[144:147], v[16:19], v[88:91]
    v_mfma_f32_16x16x32_bf16 v[92:95], v[144:147], v[20:23], v[92:95]
    v_mfma_f32_16x16x32_bf16 v[96:99], v[148:151], v[16:19], v[96:99]
    v_mfma_f32_16x16x32_bf16 v[100:103], v[148:151], v[20:23], v[100:103]
    v_mfma_f32_16x16x32_bf16 v[88:91], v[144:147], v[24:27], v[88:91]
    v_mfma_f32_16x16x32_bf16 v[92:95], v[144:147], v[28:31], v[92:95]
    v_mfma_f32_16x16x32_bf16 v[96:99], v[148:151], v[24:27], v[96:99]
    v_mfma_f32_16x16x32_bf16 v[100:103], v[148:151], v[28:31], v[100:103]
    s_waitcnt lgkmcnt(0)
    v_mfma_f32_16x16x32_bf16 v[88:91], v[152:155], v[32:35], v[88:91]
    v_mfma_f32_16x16x32_bf16 v[92:95], v[152:155], v[36:39], v[92:95]
    v_mfma_f32_16x16x32_bf16 v[96:99], v[156:159], v[32:35], v[96:99]
    v_mfma_f32_16x16x32_bf16 v[100:103], v[156:159], v[36:39], v[100:103]
    v_mfma_f32_16x16x32_bf16 v[88:91], v[152:155], v[40:43], v[88:91]
    v_mfma_f32_16x16x32_bf16 v[92:95], v[152:155], v[44:47], v[92:95]
    v_mfma_f32_16x16x32_bf16 v[96:99], v[156:159], v[40:43], v[96:99]
    v_mfma_f32_16x16x32_bf16 v[100:103], v[156:159], v[44:47], v[100:103]
    s_waitcnt vmcnt(3)
    s_barrier
    ds_read_b128 v[48:51], v10 offset:2048
    ds_read_b128 v[52:55], v10 offset:30720
    ds_read_b128 v[56:59], v11 offset:2048
    ds_read_b128 v[60:63], v11 offset:30720
    ds_read_b128 v[16:19], v10 offset:3072
    ds_read_b128 v[20:23], v10 offset:31744
    ds_read_b128 v[24:27], v11 offset:3072
    ds_read_b128 v[28:31], v11 offset:31744
    s_add_u32 m0, s63, 8192
    s_add_u32 s38, s62, 8192
    buffer_load_dwordx4 v14, s[24:27], s38 offen offset:0 sc1 lds
    buffer_load_dwordx4 v14, s[24:27], s38 offen offset:1024 sc1 lds
    buffer_load_dwordx4 v14, s[24:27], s38 offen offset:2048 sc1 lds
    s_waitcnt lgkmcnt(4)
    v_mfma_f32_16x16x32_bf16 v[88:91], v[160:163], v[48:51], v[88:91]
    ds_read_b128 v[32:35], v10 offset:4096
    v_mfma_f32_16x16x32_bf16 v[92:95], v[160:163], v[52:55], v[92:95]
    ds_read_b128 v[36:39], v10 offset:32768
    v_mfma_f32_16x16x32_bf16 v[96:99], v[164:167], v[48:51], v[96:99]
    ds_read_b128 v[40:43], v11 offset:4096
    v_mfma_f32_16x16x32_bf16 v[100:103], v[164:167], v[52:55], v[100:103]
    ds_read_b128 v[44:47], v11 offset:32768
    v_mfma_f32_16x16x32_bf16 v[88:91], v[160:163], v[56:59], v[88:91]
    v_mfma_f32_16x16x32_bf16 v[92:95], v[160:163], v[60:63], v[92:95]
    v_mfma_f32_16x16x32_bf16 v[96:99], v[164:167], v[56:59], v[96:99]
    v_mfma_f32_16x16x32_bf16 v[100:103], v[164:167], v[60:63], v[100:103]
    s_waitcnt lgkmcnt(4)
    v_mfma_f32_16x16x32_bf16 v[88:91], v[168:171], v[16:19], v[88:91]
    v_mfma_f32_16x16x32_bf16 v[92:95], v[168:171], v[20:23], v[92:95]
    v_mfma_f32_16x16x32_bf16 v[96:99], v[172:175], v[16:19], v[96:99]
    v_mfma_f32_16x16x32_bf16 v[100:103], v[172:175], v[20:23], v[100:103]
    v_mfma_f32_16x16x32_bf16 v[88:91], v[168:171], v[24:27], v[88:91]
    v_mfma_f32_16x16x32_bf16 v[92:95], v[168:171], v[28:31], v[92:95]
    v_mfma_f32_16x16x32_bf16 v[96:99], v[172:175], v[24:27], v[96:99]
    v_mfma_f32_16x16x32_bf16 v[100:103], v[172:175], v[28:31], v[100:103]
    s_waitcnt lgkmcnt(0)
    v_mfma_f32_16x16x32_bf16 v[88:91], v[176:179], v[32:35], v[88:91]
    v_mfma_f32_16x16x32_bf16 v[92:95], v[176:179], v[36:39], v[92:95]
    v_mfma_f32_16x16x32_bf16 v[96:99], v[180:183], v[32:35], v[96:99]
    v_mfma_f32_16x16x32_bf16 v[100:103], v[180:183], v[36:39], v[100:103]
    v_mfma_f32_16x16x32_bf16 v[88:91], v[176:179], v[40:43], v[88:91]
    v_mfma_f32_16x16x32_bf16 v[92:95], v[176:179], v[44:47], v[92:95]
    v_mfma_f32_16x16x32_bf16 v[96:99], v[180:183], v[40:43], v[96:99]
    v_mfma_f32_16x16x32_bf16 v[100:103], v[180:183], v[44:47], v[100:103]
    s_waitcnt vmcnt(3)
    s_barrier
    ds_read_b128 v[48:51], v10 offset:5120
    ds_read_b128 v[52:55], v10 offset:33792
    ds_read_b128 v[56:59], v11 offset:5120
    ds_read_b128 v[60:63], v11 offset:33792
    ds_read_b128 v[16:19], v10 offset:6144
    ds_read_b128 v[20:23], v10 offset:34816
    ds_read_b128 v[24:27], v11 offset:6144
    ds_read_b128 v[28:31], v11 offset:34816
    s_add_u32 m0, s63, 11264
    s_add_u32 s38, s62, 11264
    buffer_load_dwordx4 v14, s[24:27], s38 offen offset:0 sc1 lds
    buffer_load_dwordx4 v14, s[24:27], s38 offen offset:1024 sc1 lds
    buffer_load_dwordx4 v14, s[24:27], s38 offen offset:2048 sc1 lds
    s_waitcnt lgkmcnt(4)
    v_mfma_f32_16x16x32_bf16 v[88:91], v[184:187], v[48:51], v[88:91]
    ds_read_b128 v[32:35], v10 offset:7168
    v_mfma_f32_16x16x32_bf16 v[92:95], v[184:187], v[52:55], v[92:95]
    ds_read_b128 v[36:39], v10 offset:35840
    v_mfma_f32_16x16x32_bf16 v[96:99], v[188:191], v[48:51], v[96:99]
    ds_read_b128 v[40:43], v11 offset:7168
    v_mfma_f32_16x16x32_bf16 v[100:103], v[188:191], v[52:55], v[100:103]
    ds_read_b128 v[44:47], v11 offset:35840
    v_mfma_f32_16x16x32_bf16 v[88:91], v[184:187], v[56:59], v[88:91]
    v_mfma_f32_16x16x32_bf16 v[92:95], v[184:187], v[60:63], v[92:95]
    v_mfma_f32_16x16x32_bf16 v[96:99], v[188:191], v[56:59], v[96:99]
    v_mfma_f32_16x16x32_bf16 v[100:103], v[188:191], v[60:63], v[100:103]
    s_waitcnt lgkmcnt(4)
    v_mfma_f32_16x16x32_bf16 v[88:91], v[192:195], v[16:19], v[88:91]
    v_mfma_f32_16x16x32_bf16 v[92:95], v[192:195], v[20:23], v[92:95]
    v_mfma_f32_16x16x32_bf16 v[96:99], v[196:199], v[16:19], v[96:99]
    v_mfma_f32_16x16x32_bf16 v[100:103], v[196:199], v[20:23], v[100:103]
    v_mfma_f32_16x16x32_bf16 v[88:91], v[192:195], v[24:27], v[88:91]
    v_mfma_f32_16x16x32_bf16 v[92:95], v[192:195], v[28:31], v[92:95]
    v_mfma_f32_16x16x32_bf16 v[96:99], v[196:199], v[24:27], v[96:99]
    v_mfma_f32_16x16x32_bf16 v[100:103], v[196:199], v[28:31], v[100:103]
    s_waitcnt lgkmcnt(0)
    v_mfma_f32_16x16x32_bf16 v[88:91], v[200:203], v[32:35], v[88:91]
    v_mfma_f32_16x16x32_bf16 v[92:95], v[200:203], v[36:39], v[92:95]
    v_mfma_f32_16x16x32_bf16 v[96:99], v[204:207], v[32:35], v[96:99]
    v_mfma_f32_16x16x32_bf16 v[100:103], v[204:207], v[36:39], v[100:103]
    v_mfma_f32_16x16x32_bf16 v[88:91], v[200:203], v[40:43], v[88:91]
    v_mfma_f32_16x16x32_bf16 v[92:95], v[200:203], v[44:47], v[92:95]
    v_mfma_f32_16x16x32_bf16 v[96:99], v[204:207], v[40:43], v[96:99]
    v_mfma_f32_16x16x32_bf16 v[100:103], v[204:207], v[44:47], v[100:103]
    s_waitcnt vmcnt(3)
    s_barrier
    ds_read_b128 v[48:51], v10 offset:8192
    ds_read_b128 v[52:55], v10 offset:36864
    ds_read_b128 v[56:59], v11 offset:8192
    ds_read_b128 v[60:63], v11 offset:36864
    ds_read_b128 v[16:19], v10 offset:9216
    ds_read_b128 v[20:23], v10 offset:37888
    ds_read_b128 v[24:27], v11 offset:9216
    ds_read_b128 v[28:31], v11 offset:37888
    s_waitcnt lgkmcnt(4)
    v_mfma_f32_16x16x32_bf16 v[88:91], v[208:211], v[48:51], v[88:91]
    ds_read_b128 v[32:35], v10 offset:10240
    v_mfma_f32_16x16x32_bf16 v[92:95], v[208:211], v[52:55], v[92:95]
    ds_read_b128 v[36:39], v10 offset:38912
    v_mfma_f32_16x16x32_bf16 v[96:99], v[212:215], v[48:51], v[96:99]
    ds_read_b128 v[40:43], v11 offset:10240
    v_mfma_f32_16x16x32_bf16 v[100:103], v[212:215], v[52:55], v[100:103]
    ds_read_b128 v[44:47], v11 offset:38912
    v_mfma_f32_16x16x32_bf16 v[88:91], v[208:211], v[56:59], v[88:91]
    v_mfma_f32_16x16x32_bf16 v[92:95], v[208:211], v[60:63], v[92:95]
    v_mfma_f32_16x16x32_bf16 v[96:99], v[212:215], v[56:59], v[96:99]
    v_mfma_f32_16x16x32_bf16 v[100:103], v[212:215], v[60:63], v[100:103]
    s_waitcnt lgkmcnt(4)
    v_mfma_f32_16x16x32_bf16 v[88:91], v[216:219], v[16:19], v[88:91]
    v_mfma_f32_16x16x32_bf16 v[92:95], v[216:219], v[20:23], v[92:95]
    v_mfma_f32_16x16x32_bf16 v[96:99], v[220:223], v[16:19], v[96:99]
    v_mfma_f32_16x16x32_bf16 v[100:103], v[220:223], v[20:23], v[100:103]
    v_mfma_f32_16x16x32_bf16 v[88:91], v[216:219], v[24:27], v[88:91]
    v_mfma_f32_16x16x32_bf16 v[92:95], v[216:219], v[28:31], v[92:95]
    v_mfma_f32_16x16x32_bf16 v[96:99], v[220:223], v[24:27], v[96:99]
    v_mfma_f32_16x16x32_bf16 v[100:103], v[220:223], v[28:31], v[100:103]
    s_waitcnt lgkmcnt(0)
    v_mfma_f32_16x16x32_bf16 v[88:91], v[224:227], v[32:35], v[88:91]
    v_mfma_f32_16x16x32_bf16 v[92:95], v[224:227], v[36:39], v[92:95]
    v_mfma_f32_16x16x32_bf16 v[96:99], v[228:231], v[32:35], v[96:99]
    v_mfma_f32_16x16x32_bf16 v[100:103], v[228:231], v[36:39], v[100:103]
    v_mfma_f32_16x16x32_bf16 v[88:91], v[224:227], v[40:43], v[88:91]
    v_mfma_f32_16x16x32_bf16 v[92:95], v[224:227], v[44:47], v[92:95]
    v_mfma_f32_16x16x32_bf16 v[96:99], v[228:231], v[40:43], v[96:99]
    v_mfma_f32_16x16x32_bf16 v[100:103], v[228:231], v[44:47], v[100:103]
    s_waitcnt vmcnt(0)
    s_barrier
    ds_read_b128 v[48:51], v10 offset:11264
    ds_read_b128 v[52:55], v10 offset:39936
    ds_read_b128 v[56:59], v11 offset:11264
    ds_read_b128 v[60:63], v11 offset:39936
    ds_read_b128 v[16:19], v10 offset:12288
    ds_read_b128 v[20:23], v10 offset:40960
    ds_read_b128 v[24:27], v11 offset:12288
    ds_read_b128 v[28:31], v11 offset:40960
    s_waitcnt lgkmcnt(4)
    v_mfma_f32_16x16x32_bf16 v[88:91], v[232:235], v[48:51], v[88:91]
    ds_read_b128 v[32:35], v10 offset:13312
    v_mfma_f32_16x16x32_bf16 v[92:95], v[232:235], v[52:55], v[92:95]
    ds_read_b128 v[36:39], v10 offset:41984
    v_mfma_f32_16x16x32_bf16 v[96:99], v[236:239], v[48:51], v[96:99]
    ds_read_b128 v[40:43], v11 offset:13312
    v_mfma_f32_16x16x32_bf16 v[100:103], v[236:239], v[52:55], v[100:103]
    ds_read_b128 v[44:47], v11 offset:41984
    v_mfma_f32_16x16x32_bf16 v[88:91], v[232:235], v[56:59], v[88:91]
    v_mfma_f32_16x16x32_bf16 v[92:95], v[232:235], v[60:63], v[92:95]
    v_mfma_f32_16x16x32_bf16 v[96:99], v[236:239], v[56:59], v[96:99]
    v_mfma_f32_16x16x32_bf16 v[100:103], v[236:239], v[60:63], v[100:103]
    s_waitcnt lgkmcnt(4)
    v_mfma_f32_16x16x32_bf16 v[88:91], v[240:243], v[16:19], v[88:91]
    v_mfma_f32_16x16x32_bf16 v[92:95], v[240:243], v[20:23], v[92:95]
    v_mfma_f32_16x16x32_bf16 v[96:99], v[244:247], v[16:19], v[96:99]
    v_mfma_f32_16x16x32_bf16 v[100:103], v[244:247], v[20:23], v[100:103]
    v_mfma_f32_16x16x32_bf16 v[88:91], v[240:243], v[24:27], v[88:91]
    v_mfma_f32_16x16x32_bf16 v[92:95], v[240:243], v[28:31], v[92:95]
    v_mfma_f32_16x16x32_bf16 v[96:99], v[244:247], v[24:27], v[96:99]
    v_mfma_f32_16x16x32_bf16 v[100:103], v[244:247], v[28:31], v[100:103]
    s_waitcnt lgkmcnt(0)
    v_mfma_f32_16x16x32_bf16 v[88:91], v[248:251], v[32:35], v[88:91]
    v_mfma_f32_16x16x32_bf16 v[92:95], v[248:251], v[36:39], v[92:95]
    v_mfma_f32_16x16x32_bf16 v[96:99], v[252:255], v[32:35], v[96:99]
    v_mfma_f32_16x16x32_bf16 v[100:103], v[252:255], v[36:39], v[100:103]
    v_mfma_f32_16x16x32_bf16 v[88:91], v[248:251], v[40:43], v[88:91]
    v_mfma_f32_16x16x32_bf16 v[92:95], v[248:251], v[44:47], v[92:95]
    v_mfma_f32_16x16x32_bf16 v[96:99], v[252:255], v[40:43], v[96:99]
    v_mfma_f32_16x16x32_bf16 v[100:103], v[252:255], v[44:47], v[100:103]
    s_lshl_b32 s37, s36, 11
    s_add_u32 s37, s37, 114688
    s_xor_b32 s38, s37, 2048
    v_add_u32 v2, s37, v14
    v_add_u32 v3, s38, v14
    s_mov_b32 s16, s14
    s_and_b32 s17, s15, 0xffff
    s_mov_b32 s18, 1835008
    s_mov_b32 s19, 0x20000
    v_and_b32 v4, 15, v1
    v_mul_u32_u24 v4, 896, v4
    v_lshrrev_b32 v5, 4, v1
    v_lshl_add_u32 v4, v5, 3, v4
    s_lshl_b32 s37, s42, 6
    s_lshl_b32 s38, s41, 5
    s_add_u32 s37, s37, s38
    s_and_b32 s39, s36, 1
    s_lshl_b32 s38, s39, 4
    s_add_u32 s37, s37, s38
    s_mul_i32 s37, s37, 896
    s_mul_i32 s38, s43, 224
    s_add_u32 s37, s37, s38
    s_lshr_b32 s38, s36, 1
    s_lshl_b32 s38, s38, 6
    s_add_u32 s37, s37, s38
    s_cmp_eq_u32 s39, 0
    s_cbranch_scc1 L_x0
    v_swap_b32 v88, v92
    v_swap_b32 v89, v93
    v_swap_b32 v90, v94
    v_swap_b32 v91, v95
    v_swap_b32 v96, v100
    v_swap_b32 v97, v101
    v_swap_b32 v98, v102
    v_swap_b32 v99, v103
L_x0:
    ds_write_b128 v2, v[92:95] offset:0
    ds_write_b128 v2, v[100:103] offset:1024
    s_waitcnt lgkmcnt(0)
    s_barrier
    ds_read_b128 v[16:19], v3 offset:0
    ds_read_b128 v[20:23], v3 offset:1024
    s_waitcnt lgkmcnt(1)
    v_add_f32 v88, v88, v16
    v_add_f32 v89, v89, v17
    v_add_f32 v90, v90, v18
    v_add_f32 v91, v91, v19
    v_cvt_pk_bf16_f32 v24, v88, v89
    v_cvt_pk_bf16_f32 v25, v90, v91
    buffer_store_dwordx2 v[24:25], v4, s[16:19], s37 offen offset:0
    s_cmp_ge_u32 s36, 6
    s_cbranch_scc1 L_fin
    s_waitcnt lgkmcnt(0)
    v_add_f32 v96, v96, v20
    v_add_f32 v97, v97, v21
    v_add_f32 v98, v98, v22
    v_add_f32 v99, v99, v23
    v_cvt_pk_bf16_f32 v26, v96, v97
    v_cvt_pk_bf16_f32 v27, v98, v99
    buffer_store_dwordx2 v[26:27], v4, s[16:19], s37 offen offset:32
L_fin:
    s_endpgm
L_ldtail:
    s_mov_b32 s24, s58
    s_and_b32 s25, s59, 0xffff
    s_mov_b32 s26, 8146944
    s_mov_b32 s27, 0x20000
    s_and_b32 s37, s36, 1
    s_mul_i32 s37, s37, 14
    s_lshr_b32 s38, s36, 1
    s_mul_i32 s39, s38, 56
    s_add_u32 s37, s37, s39
    s_mul_i32 s39, s43, 196
    s_add_u32 s37, s37, s39
    s_lshl_b32 s37, s37, 10
    s_add_u32 s60, s37, 7340032
    s_add_u32 s61, s37, 7368704
    s_cmp_eq_u32 s38, 3
    s_cselect_b32 s61, 0x7f000000, s61
    s_and_b32 s37, s36, 3
    s_lshr_b32 s38, s36, 2
    s_mul_i32 s38, s38, 14
    s_mul_i32 s63, s37, 28
    s_add_u32 s63, s63, s38
    s_lshl_b32 s63, s63, 10
    s_lshr_b32 s39, s37, 1
    s_lshl_b32 s39, s39, 7
    s_and_b32 s37, s37, 1
    s_add_u32 s37, s37, s39
    s_lshl_b32 s39, s42, 2
    s_add_u32 s37, s37, s39
    s_lshl_b32 s39, s41, 1
    s_add_u32 s37, s37, s39
    s_mul_i32 s37, s37, 28
    s_add_u32 s37, s37, s38
    s_lshl_b32 s62, s37, 10
    v_mov_b32 v2, v14
    v_add_u32 v3, 4096, v14
    v_add_u32 v4, 8192, v14
    v_add_u32 v5, 12288, v14
    s_waitcnt vmcnt(28)
    s_barrier
    buffer_load_dwordx4 v[144:147], v2, s[24:27], s60 offen offset:0 sc1
    buffer_load_dwordx4 v[148:151], v2, s[24:27], s61 offen offset:0 sc1
    buffer_load_dwordx4 v[152:155], v2, s[24:27], s60 offen offset:1024 sc1
    buffer_load_dwordx4 v[156:159], v2, s[24:27], s61 offen offset:1024 sc1
    buffer_load_dwordx4 v[160:163], v2, s[24:27], s60 offen offset:2048 sc1
    buffer_load_dwordx4 v[164:167], v2, s[24:27], s61 offen offset:2048 sc1
    buffer_load_dwordx4 v[168:171], v2, s[24:27], s60 offen offset:3072 sc1
    s_waitcnt vmcnt(21)
    s_barrier
    buffer_load_dwordx4 v[172:175], v2, s[24:27], s61 offen offset:3072 sc1
    buffer_load_dwordx4 v[176:179], v3, s[24:27], s60 offen offset:0 sc1
    buffer_load_dwordx4 v[180:183], v3, s[24:27], s61 offen offset:0 sc1
    buffer_load_dwordx4 v[184:187], v3, s[24:27], s60 offen offset:1024 sc1
    buffer_load_dwordx4 v[188:191], v3, s[24:27], s61 offen offset:1024 sc1
    buffer_load_dwordx4 v[192:195], v3, s[24:27], s60 offen offset:2048 sc1
    buffer_load_dwordx4 v[196:199], v3, s[24:27], s61 offen offset:2048 sc1
    buffer_load_dwordx4 v[200:203], v3, s[24:27], s60 offen offset:3072 sc1
    buffer_load_dwordx4 v[204:207], v3, s[24:27], s61 offen offset:3072 sc1
    buffer_load_dwordx4 v[208:211], v4, s[24:27], s60 offen offset:0 sc1
    buffer_load_dwordx4 v[212:215], v4, s[24:27], s61 offen offset:0 sc1
    buffer_load_dwordx4 v[216:219], v4, s[24:27], s60 offen offset:1024 sc1
    buffer_load_dwordx4 v[220:223], v4, s[24:27], s61 offen offset:1024 sc1
    buffer_load_dwordx4 v[224:227], v4, s[24:27], s60 offen offset:2048 sc1
    s_waitcnt vmcnt(21)
    s_barrier
    buffer_load_dwordx4 v[228:231], v4, s[24:27], s61 offen offset:2048 sc1
    buffer_load_dwordx4 v[232:235], v4, s[24:27], s60 offen offset:3072 sc1
    buffer_load_dwordx4 v[236:239], v4, s[24:27], s61 offen offset:3072 sc1
    buffer_load_dwordx4 v[240:243], v5, s[24:27], s60 offen offset:0 sc1
    buffer_load_dwordx4 v[244:247], v5, s[24:27], s61 offen offset:0 sc1
    buffer_load_dwordx4 v[248:251], v5, s[24:27], s60 offen offset:1024 sc1
    buffer_load_dwordx4 v[252:255], v5, s[24:27], s61 offen offset:1024 sc1
    s_branch L_p2
L_aux:
    s_lshl_b32 s52, s42, 3
    s_lshl_b32 s37, s41, 2
    s_add_u32 s52, s52, s37
    s_add_u32 s52, s52, s43
    s_mov_b32 s51, 0
    s_waitcnt lgkmcnt(0)
    s_mov_b32 s24, s58
    s_and_b32 s25, s59, 0xffff
    s_mov_b32 s26, 8146944
    s_mov_b32 s27, 0x20000
    s_cmp_eq_u32 s36, 7
    s_cbranch_scc1 L_aux7
    v_and_b32 v2, 15, v1
    v_mul_u32_u24 v2, 896, v2
    v_lshrrev_b32 v3, 4, v1
    v_lshl_add_u32 v2, v3, 3, v2
    s_mul_i32 s37, s52, 9363
    s_lshr_b32 s37, s37, 16
    s_mul_i32 s38, s37, 7
    s_sub_u32 s38, s52, s38
    s_mul_i32 s37, s37, 14336
    s_lshl_b32 s38, s38, 7
    s_add_u32 s37, s37, s38
    s_mov_b32 s20, s10
    s_and_b32 s21, s11, 0xffff
    s_mov_b32 s22, 401408
    s_mov_b32 s23, 0x20000
    s_mov_b32 s28, s12
    s_and_b32 s29, s13, 0xffff
    s_mov_b32 s30, 401408
    s_mov_b32 s31, 0x20000
    buffer_load_dwordx2 v[16:17], v2, s[20:23], s37 offen offset:0
    buffer_load_dwordx2 v[18:19], v2, s[28:31], s37 offen offset:0
    buffer_load_dwordx2 v[20:21], v2, s[20:23], s37 offen offset:32
    buffer_load_dwordx2 v[22:23], v2, s[28:31], s37 offen offset:32
    buffer_load_dwordx2 v[24:25], v2, s[20:23], s37 offen offset:64
    buffer_load_dwordx2 v[26:27], v2, s[28:31], s37 offen offset:64
    buffer_load_dwordx2 v[28:29], v2, s[20:23], s37 offen offset:96
    buffer_load_dwordx2 v[30:31], v2, s[28:31], s37 offen offset:96
    s_lshl_b32 s38, s42, 7
    s_and_b32 s39, s52, 7
    s_lshl_b32 s39, s39, 2
    s_add_u32 s38, s38, s39
    s_add_u32 s38, s38, 8142848
    v_mov_b32 v4, 0
    s_mov_b64 exec, 1
    buffer_store_dword v4, v4, s[24:27], s38 offen
    buffer_load_dword v5, v4, s[24:27], s38 offen sc1
    s_mov_b64 exec, -1
    s_getreg_b32 s54, hwreg(HW_REG_XCC_ID)
    s_and_b32 s54, s54, 7
    s_lshr_b32 s38, s42, 3
    s_lshl_b32 s38, s38, 6
    s_and_b32 s39, s42, 7
    s_lshl_b32 s39, s39, 2
    s_add_u32 s38, s38, s39
    s_add_u32 s38, s38, 32
    s_add_u32 s32, s56, s38
    s_addc_u32 s33, s57, 0
    s_cmp_ge_u32 s52, 196
    s_cbranch_scc1 L_aux_nod
    s_lshl_b32 s37, s52, 12
    s_add_u32 s37, s37, 7340032
    s_waitcnt vmcnt(0)
    v_xor_b32 v18, 0x80008000, v18
    v_xor_b32 v19, 0x80008000, v19
    buffer_store_dwordx4 v[16:19], v14, s[24:27], s37 offen offset:0 sc1
    v_xor_b32 v22, 0x80008000, v22
    v_xor_b32 v23, 0x80008000, v23
    buffer_store_dwordx4 v[20:23], v14, s[24:27], s37 offen offset:1024 sc1
    v_xor_b32 v26, 0x80008000, v26
    v_xor_b32 v27, 0x80008000, v27
    buffer_store_dwordx4 v[24:27], v14, s[24:27], s37 offen offset:2048 sc1
    v_xor_b32 v30, 0x80008000, v30
    v_xor_b32 v31, 0x80008000, v31
    buffer_store_dwordx4 v[28:31], v14, s[24:27], s37 offen offset:3072 sc1
L_aux_nod:
    s_barrier
    s_barrier
    s_waitcnt vmcnt(0)
    s_and_b32 s37, s52, 7
    s_mul_i32 s37, s37, 3
    s_lshl_b32 s37, s54, s37
    s_add_u32 s37, s37, 0x1000000
    s_atomic_add s37, s[32:33], 0
    s_cmp_ge_u32 s52, 196
    s_cbranch_scc1 L_aux_nod2
    s_mul_i32 s38, s52, 1338
    s_lshr_b32 s38, s38, 16
    s_lshl_b32 s38, s38, 6
    s_add_u32 s34, s56, s38
    s_addc_u32 s35, s57, 0
    s_mov_b32 s38, 1
    s_atomic_add s38, s[34:35], 0
L_aux_nod2:
    s_barrier
    s_barrier
    s_barrier
    s_barrier
    s_barrier
    s_barrier
    s_barrier
    s_barrier
    s_waitcnt lgkmcnt(0)
    s_lshl_b32 s38, s43, 6
    s_add_u32 s34, s56, s38
    s_addc_u32 s35, s57, 0
    s_mov_b32 s39, 0
    s_mov_b32 s40, 0
    s_atomic_add s39, s[32:33], 0 glc
    s_atomic_add s40, s[34:35], 0 glc
    s_barrier
    s_barrier
L_poll1:
    s_waitcnt lgkmcnt(0)
    s_add_u32 s51, s51, 1
    s_lshr_b32 s37, s39, 24
    s_and_b32 s37, s37, 15
    s_lshl_b32 s37, s37, 8
    s_add_u32 s37, s37, s40
    s_cmp_eq_u32 s37, 2097
    s_cbranch_scc1 L_poll1_done
    s_cmp_ge_u32 s51, 16384
    s_cbranch_scc1 L_poll1_done
    s_sleep 16
    s_mov_b32 s39, 0
    s_mov_b32 s40, 0
    s_atomic_add s39, s[32:33], 0 glc
    s_atomic_add s40, s[34:35], 0 glc
    s_branch L_poll1
L_poll1_done:
    s_mul_i32 s37, s54, 0x249249
    s_and_b32 s39, s39, 0xffffff
    s_cmp_eq_u32 s39, s37
    s_cselect_b32 s53, 1, 0
    s_branch L_aux_pre
L_aux7:
    s_waitcnt vmcnt(0)
    s_barrier
    s_barrier
    s_barrier
    s_barrier
    s_barrier
    s_barrier
    s_barrier
    s_barrier
    s_barrier
    s_barrier
    s_barrier
    s_barrier
L_aux_pre:
    s_and_b32 s37, s36, 1
    s_mul_i32 s37, s37, 14
    s_lshr_b32 s38, s36, 1
    s_mul_i32 s39, s38, 56
    s_add_u32 s37, s37, s39
    s_mul_i32 s39, s43, 196
    s_add_u32 s37, s37, s39
    s_lshl_b32 s37, s37, 10
    s_add_u32 s60, s37, 7340032
    s_add_u32 s61, s37, 7368704
    s_cmp_eq_u32 s38, 3
    s_cselect_b32 s61, 0x7f000000, s61
    s_and_b32 s37, s36, 3
    s_lshr_b32 s38, s36, 2
    s_mul_i32 s38, s38, 14
    s_mul_i32 s63, s37, 28
    s_add_u32 s63, s63, s38
    s_lshl_b32 s63, s63, 10
    s_lshr_b32 s39, s37, 1
    s_lshl_b32 s39, s39, 7
    s_and_b32 s37, s37, 1
    s_add_u32 s37, s37, s39
    s_lshl_b32 s39, s42, 2
    s_add_u32 s37, s37, s39
    s_lshl_b32 s39, s41, 1
    s_add_u32 s37, s37, s39
    s_mul_i32 s37, s37, 28
    s_add_u32 s37, s37, s38
    s_lshl_b32 s62, s37, 10
    v_mov_b32 v2, v14
    v_add_u32 v3, 4096, v14
    v_add_u32 v4, 8192, v14
    v_add_u32 v5, 12288, v14
    s_barrier
    s_barrier
    buffer_load_dwordx4 v[144:147], v2, s[24:27], s60 offen offset:0 sc1
    buffer_load_dwordx4 v[148:151], v2, s[24:27], s61 offen offset:0 sc1
    buffer_load_dwordx4 v[152:155], v2, s[24:27], s60 offen offset:1024 sc1
    buffer_load_dwordx4 v[156:159], v2, s[24:27], s61 offen offset:1024 sc1
    buffer_load_dwordx4 v[160:163], v2, s[24:27], s60 offen offset:2048 sc1
    buffer_load_dwordx4 v[164:167], v2, s[24:27], s61 offen offset:2048 sc1
    buffer_load_dwordx4 v[168:171], v2, s[24:27], s60 offen offset:3072 sc1
    s_barrier
    buffer_load_dwordx4 v[172:175], v2, s[24:27], s61 offen offset:3072 sc1
    buffer_load_dwordx4 v[176:179], v3, s[24:27], s60 offen offset:0 sc1
    buffer_load_dwordx4 v[180:183], v3, s[24:27], s61 offen offset:0 sc1
    buffer_load_dwordx4 v[184:187], v3, s[24:27], s60 offen offset:1024 sc1
    buffer_load_dwordx4 v[188:191], v3, s[24:27], s61 offen offset:1024 sc1
    buffer_load_dwordx4 v[192:195], v3, s[24:27], s60 offen offset:2048 sc1
    buffer_load_dwordx4 v[196:199], v3, s[24:27], s61 offen offset:2048 sc1
    buffer_load_dwordx4 v[200:203], v3, s[24:27], s60 offen offset:3072 sc1
    buffer_load_dwordx4 v[204:207], v3, s[24:27], s61 offen offset:3072 sc1
    buffer_load_dwordx4 v[208:211], v4, s[24:27], s60 offen offset:0 sc1
    buffer_load_dwordx4 v[212:215], v4, s[24:27], s61 offen offset:0 sc1
    buffer_load_dwordx4 v[216:219], v4, s[24:27], s60 offen offset:1024 sc1
    buffer_load_dwordx4 v[220:223], v4, s[24:27], s61 offen offset:1024 sc1
    buffer_load_dwordx4 v[224:227], v4, s[24:27], s60 offen offset:2048 sc1
    s_barrier
    buffer_load_dwordx4 v[228:231], v4, s[24:27], s61 offen offset:2048 sc1
    buffer_load_dwordx4 v[232:235], v4, s[24:27], s60 offen offset:3072 sc1
    buffer_load_dwordx4 v[236:239], v4, s[24:27], s61 offen offset:3072 sc1
    buffer_load_dwordx4 v[240:243], v5, s[24:27], s60 offen offset:0 sc1
    buffer_load_dwordx4 v[244:247], v5, s[24:27], s61 offen offset:0 sc1
    buffer_load_dwordx4 v[248:251], v5, s[24:27], s60 offen offset:1024 sc1
    buffer_load_dwordx4 v[252:255], v5, s[24:27], s61 offen offset:1024 sc1
    s_branch L_p2
L_done:
    s_endpgm
L_end:
.section .rodata,"a"
.p2align 6
.amdhsa_kernel standalone__spectral_fnet__prompt_kernel
  .amdhsa_next_free_vgpr 256
  .amdhsa_next_free_sgpr 100
  .amdhsa_accum_offset 256
  .amdhsa_group_segment_fixed_size 0
  .amdhsa_kernarg_size 64
  .amdhsa_user_sgpr_count 2
  .amdhsa_user_sgpr_kernarg_segment_ptr 1
  .amdhsa_system_sgpr_workgroup_id_x 1
  .amdhsa_float_denorm_mode_32 3
  .amdhsa_float_denorm_mode_16_64 3
.end_amdhsa_kernel
```
